```python
import torch

def _softmax(x, axis=-1):
    return torch.softmax(x, dim=axis)

def _gelu(x):
    return torch.nn.functional.gelu(x, approximate='tanh')

def _silu(x):
    return torch.nn.functional.silu(x)

def _sigmoid(x):
    return torch.sigmoid(x)

def _layernorm(x, axis=-1, eps=1e-05):
    m = x.mean(dim=axis, keepdim=True)
    v = x.var(dim=axis, keepdim=True, unbiased=False)
    return (x - m) / torch.sqrt(v + eps)

def _scatter_add(tgt, idx, src, axis=0):
    return tgt.clone().index_add_(axis, idx, src)

def _segment_sum(src, seg, n):
    out = torch.zeros((n,) + src.shape[1:], dtype=src.dtype)
    return out.index_add_(0, seg, src)

def _pad(x, pw):
    flat = tuple((v for pair in reversed(pw) for v in pair))
    return torch.nn.functional.pad(x, flat)
kernel_name = 'standalone__kv_cache_quant_pre_rope_vs_post_rope__sampling'

def setup_inputs():

    _w = lambda a: (lambda t: t.to(torch.bfloat16) if t.is_floating_point() else t)(torch.as_tensor(a))
    B, Sq, Skv = (8, 1, 8192)
    H, Dh0 = (8, 128)
    G = -1 if -1 > 0 else Dh0
    G = max(2, G // 2 * 2)
    Dh = max(G, Dh0 // G * G)
    Skv = max(Skv, Sq)
    ng = Dh // G
    bits = 4 if 4 > 1 else 4
    bits = max(2, min(8, bits))
    qmax = (1 << bits) - 1
    half = Dh // 2
    inv = 1.0 / 10000.0 ** (torch.arange(half) / max(1, half))
    ang_k = torch.arange(Skv)[:, None] * inv[None, :]
    ang_q = torch.arange(Skv - Sq, Skv)[:, None] * inv[None, :]
    kc = torch.cat([torch.cos(ang_k), torch.cos(ang_k)], dim=-1)
    ks = torch.cat([torch.sin(ang_k), torch.sin(ang_k)], dim=-1)
    qc = torch.cat([torch.cos(ang_q), torch.cos(ang_q)], dim=-1)
    qs = torch.cat([torch.sin(ang_q), torch.sin(ang_q)], dim=-1)
    qk_i = torch.randint(0, qmax + 1, (B, H, Skv, Dh)).to(torch.int32)
    qv_i = torch.randint(0, qmax + 1, (B, H, Skv, Dh)).to(torch.int32)
    ksc = torch.abs((lambda *s: torch.randn(*s, dtype=torch.bfloat16) * 0.2)(B, H, Skv, ng)) * 0.1 + 0.01
    kzp = torch.full((B, H, Skv, ng), qmax / 2.0)
    vsc = torch.abs((lambda *s: torch.randn(*s, dtype=torch.bfloat16) * 0.2)(B, H, Skv, ng)) * 0.1 + 0.01
    vzp = torch.full((B, H, Skv, ng), qmax / 2.0)
    return {'q': _w((lambda *s: torch.randn(*s, dtype=torch.bfloat16) * 6.4)(B, H, Sq, Dh) * 0.5), 'qk': _w(qk_i), 'k_scales': _w(ksc), 'k_zeros': _w(kzp), 'qv': _w(qv_i), 'v_scales': _w(vsc), 'v_zeros': _w(vzp), 'q_cos': _w(qc), 'q_sin': _w(qs), 'k_cos': _w(kc), 'k_sin': _w(ks)}

def reference(q, qk, k_scales, k_zeros, qv, v_scales, v_zeros, q_cos, q_sin, k_cos, k_sin):
    B, H, Sq, Dh = q.shape
    ng = k_scales.shape[-1]
    G = Dh // ng
    half = Dh // 2
    ks = (lambda x, n, axis: torch.repeat_interleave(x, n, dim=axis))(k_scales, G, axis=-1)
    kz = (lambda x, n, axis: torch.repeat_interleave(x, n, dim=axis))(k_zeros, G, axis=-1)
    k = ((lambda x, dt: x.to(dt))(qk, q.dtype) - kz) * ks
    vs = (lambda x, n, axis: torch.repeat_interleave(x, n, dim=axis))(v_scales, G, axis=-1)
    vz = (lambda x, n, axis: torch.repeat_interleave(x, n, dim=axis))(v_zeros, G, axis=-1)
    v = ((lambda x, dt: x.to(dt))(qv, q.dtype) - vz) * vs
    k1 = k[..., :half].clone()
    k2 = k[..., half:].clone()
    krh = torch.concatenate([-k2, k1], axis=-1)
    kr = k * k_cos[None, None, :, :] + krh * k_sin[None, None, :, :]
    q1 = q[..., :half].clone()
    q2 = q[..., half:].clone()
    qrh = torch.concatenate([-q2, q1], axis=-1)
    qr = q * q_cos[None, None, :, :] + qrh * q_sin[None, None, :, :]
    logits = torch.einsum('bhqd,bhkd->bhqk', qr, kr) * float(Dh) ** (-0.5)
    attn = _softmax(logits, axis=-1)
    out = torch.einsum('bhqk,bhkd->bhqd', attn, v)
    return out
```

```asm
; @launch grid=(256,1,1) block=(256,1,1) lds=86016
.amdgcn_target "amdgcn-amd-amdhsa--gfx950"
.text
.globl standalone__kv_cache_quant_pre_rope_vs_post_rope__sampling_kernel
.p2align 8
.type standalone__kv_cache_quant_pre_rope_vs_post_rope__sampling_kernel,@function
standalone__kv_cache_quant_pre_rope_vs_post_rope__sampling_kernel:
  s_cmp_ge_u32 s2, 256
  s_cbranch_scc1 LA_done
  s_load_dwordx16 s[40:55], s[0:1], 0
  s_load_dwordx8 s[56:63], s[0:1], 64
  s_load_dwordx4 s[64:67], s[0:1], 96
  s_memrealtime s[92:93]
  v_and_b32 v10, 31, v0
  v_bfe_u32 v11, v0, 5, 1
  v_lshrrev_b32 v12, 6, v0
  v_lshlrev_b32 v1, 4, v10
  v_readfirstlane_b32 s74, v12
  v_lshl_add_u32 v1, v11, 11, v1
  v_lshlrev_b32 v2, 3, v10
  v_lshl_add_u32 v2, v11, 10, v2
  v_xor_b32 v3, 128, v2
  v_mov_b32 v6, 0
  s_and_b32 s72, s2, 7
  s_lshr_b32 s73, s2, 3
  s_lshr_b32 s89, s72, 2
  s_mul_i32 s89, s89, 128
  s_and_b32 s87, s72, 3
  s_lshl_b32 s87, s87, 1
  s_add_u32 s89, s89, s87
  s_mul_i32 s89, s89, 4
  s_add_u32 s89, s89, s74
  s_mov_b32 s76, 1
  s_mov_b32 s6, 0x10000000
  s_mov_b32 s7, 0x20000
  s_mov_b32 s10, 0x10000000
  s_mov_b32 s11, 0x20000
  s_mov_b32 s14, 0x200000
  s_mov_b32 s15, 0x20000
  s_mov_b32 s18, 0x200000
  s_mov_b32 s19, 0x20000
  s_mov_b32 s22, 0x40000000
  s_mov_b32 s23, 0x20000
  s_lshl_b32 s77, s73, 23
  s_lshl_b32 s87, s89, 12
  s_add_u32 s77, s77, s87
  s_add_u32 s78, s77, 0x400000
  s_lshl_b32 s79, s89, 11
  s_lshl_b32 s80, s73, 15
  s_lshl_b32 s87, s89, 4
  s_add_u32 s80, s80, s87
  s_add_u32 s81, s80, 0x4000
  s_cmp_lg_u32 s76, 0
  s_cselect_b32 s77, s77, 0x10000000
  s_cselect_b32 s78, s78, 0x10000000
  s_cselect_b32 s79, s79, 0x200000
  s_cselect_b32 s80, s80, 0
  s_cselect_b32 s81, s81, 0
  s_waitcnt lgkmcnt(0)
  s_mov_b64 s[4:5], s[42:43]
  s_mov_b64 s[8:9], s[48:49]
  s_mov_b64 s[12:13], s[58:59]
  s_mov_b64 s[16:17], s[60:61]
  s_mov_b64 s[20:21], s[66:67]
  s_mov_b64 s[24:25], s[46:47]
  s_mov_b64 s[26:27], s[44:45]
  s_mov_b64 s[28:29], s[50:51]
  s_mov_b64 s[30:31], s[52:53]
  s_mov_b64 s[32:33], s[64:65]
  s_mov_b64 s[34:35], s[62:63]
  s_mov_b64 s[96:97], s[40:41]
  s_mov_b64 s[98:99], s[54:55]
  s_mov_b64 s[100:101], s[56:57]
  v_lshlrev_b32 v30, 3, v10
  v_xor_b32 v31, 128, v30
  s_lshl_b32 s87, s73, 9
  s_add_u32 s96, s96, s87
  s_addc_u32 s97, s97, 0
  s_cmp_lg_u32 s74, 0
  s_cbranch_scc1 LA_nomb
  v_and_b32 v32, 63, v0
  v_lshlrev_b32 v32, 2, v32
  ds_write_b32 v32, v6 offset:24576
  s_waitcnt lgkmcnt(0)
LA_nomb:
  global_load_dwordx2 v[180:181], v30, s[96:97] offset:0
  global_load_dwordx2 v[182:183], v31, s[96:97] offset:0
  global_load_dwordx2 v[184:185], v30, s[96:97] offset:256
  global_load_dwordx2 v[186:187], v31, s[96:97] offset:256
  global_load_dwordx2 v[188:189], v30, s[98:99] offset:0
  global_load_dwordx2 v[190:191], v31, s[98:99] offset:0
  global_load_dwordx2 v[192:193], v30, s[100:101] offset:0
  global_load_dwordx2 v[194:195], v31, s[100:101] offset:0
  buffer_load_dwordx2 v[100:101], v2, s[12:15], s79 offen offset:0
  buffer_load_dwordx2 v[102:103], v3, s[16:19], s79 offen offset:0
  buffer_load_dwordx2 v[104:105], v2, s[12:15], s79 offen offset:256
  buffer_load_dwordx2 v[106:107], v3, s[16:19], s79 offen offset:256
  buffer_load_dwordx2 v[108:109], v2, s[12:15], s79 offen offset:512
  buffer_load_dwordx2 v[110:111], v3, s[16:19], s79 offen offset:512
  buffer_load_dwordx2 v[112:113], v2, s[12:15], s79 offen offset:768
  buffer_load_dwordx2 v[114:115], v3, s[16:19], s79 offen offset:768
  buffer_load_dwordx4 v[116:119], v1, s[4:7], s77 offen offset:0 nt
  buffer_load_dwordx4 v[120:123], v1, s[4:7], s77 offen offset:512 nt
  buffer_load_dwordx4 v[124:127], v1, s[4:7], s77 offen offset:1024 nt
  buffer_load_dwordx4 v[128:131], v1, s[4:7], s77 offen offset:1536 nt
  buffer_load_dwordx4 v[132:135], v1, s[4:7], s78 offen offset:0 nt
  buffer_load_dwordx4 v[136:139], v1, s[4:7], s78 offen offset:512 nt
  buffer_load_dwordx4 v[140:143], v1, s[4:7], s78 offen offset:1024 nt
  buffer_load_dwordx4 v[144:147], v1, s[4:7], s78 offen offset:1536 nt
  buffer_load_dwordx4 v[148:151], v1, s[8:11], s77 offen offset:0 nt
  buffer_load_dwordx4 v[152:155], v1, s[8:11], s77 offen offset:512 nt
  buffer_load_dwordx4 v[156:159], v1, s[8:11], s77 offen offset:1024 nt
  buffer_load_dwordx4 v[160:163], v1, s[8:11], s77 offen offset:1536 nt
  s_load_dwordx4 s[40:43], s[24:25], s80
  s_load_dwordx4 s[44:47], s[26:27], s80
  s_load_dwordx4 s[48:51], s[28:29], s80
  s_load_dwordx4 s[52:55], s[30:31], s80
  s_load_dwordx4 s[56:59], s[24:25], s81
  s_load_dwordx4 s[60:63], s[26:27], s81
  s_load_dwordx4 s[64:67], s[28:29], s81
  s_load_dwordx4 s[68:71], s[30:31], s81
  s_lshl_b32 s87, s73, 2
  s_add_u32 s87, s87, 128
  s_add_u32 s32, s32, s87
  s_addc_u32 s33, s33, 0
  s_lshl_b32 s87, s73, 8
  s_add_u32 s87, s87, 0x100000
  s_add_u32 s36, s20, s87
  s_addc_u32 s37, s21, 0
  v_mov_b32 v7, 1
  s_mov_b32 s90, 0
  s_and_b32 s87, s73, 7
  s_cmp_lg_u32 s87, s72
  s_cbranch_scc1 LA_noinit
  s_cmp_lg_u32 s74, 0
  s_cbranch_scc1 LA_noinit
  s_mov_b64 exec, 1
  global_atomic_swap v8, v6, v6, s[36:37] sc0
  s_waitcnt vmcnt(0) lgkmcnt(0)
  s_or_b32 s90, s92, 1
  v_mov_b32 v8, s90
  global_store_dword v6, v8, s[32:33] sc1
  s_mov_b64 exec, -1
LA_noinit:
  v_bfe_u32 v13, v0, 4, 1
  v_mov_b32 v5, 0x01000c0c
  v_mov_b32 v14, 0x03020c0c
  v_cmp_eq_u32 vcc, 1, v13
  s_nop 1
  v_cndmask_b32 v5, v5, v14, vcc
  v_lshlrev_b32 v62, 27, v10
  v_and_b32 v62, 0x80000000, v62
  s_mov_b32 s84, 0x05040100
  s_mov_b32 s85, 0x07060302
  s_mov_b32 s86, 0x3e0293ee
  s_waitcnt vmcnt(20)
  v_lshlrev_b32 v32, 16, v188
  v_and_b32 v33, 0xffff0000, v188
  v_lshlrev_b32 v34, 16, v189
  v_and_b32 v35, 0xffff0000, v189
  v_lshlrev_b32 v36, 16, v190
  v_and_b32 v37, 0xffff0000, v190
  v_lshlrev_b32 v38, 16, v191
  v_and_b32 v39, 0xffff0000, v191
  v_lshlrev_b32 v40, 16, v192
  v_and_b32 v41, 0xffff0000, v192
  v_lshlrev_b32 v42, 16, v193
  v_and_b32 v43, 0xffff0000, v193
  v_lshlrev_b32 v44, 16, v194
  v_and_b32 v45, 0xffff0000, v194
  v_lshlrev_b32 v46, 16, v195
  v_and_b32 v47, 0xffff0000, v195
  v_lshlrev_b32 v48, 16, v180
  v_and_b32 v49, 0xffff0000, v180
  v_lshlrev_b32 v50, 16, v181
  v_and_b32 v51, 0xffff0000, v181
  v_lshlrev_b32 v52, 16, v182
  v_and_b32 v53, 0xffff0000, v182
  v_lshlrev_b32 v54, 16, v183
  v_and_b32 v55, 0xffff0000, v183
  v_mul_f32 v56, v48, v32
  v_mul_f32 v57, v52, v40
  v_mul_f32 v58, v52, v36
  v_mul_f32 v59, v48, v44
  v_xor_b32 v57, v62, v57
  v_xor_b32 v57, 0x80000000, v57
  v_xor_b32 v59, v62, v59
  v_cvt_pk_bf16_f32 v60, v56, v57
  v_cvt_pk_bf16_f32 v61, v58, v59
  v_lshlrev_b32 v56, 16, v60
  v_and_b32 v57, 0xffff0000, v60
  v_lshlrev_b32 v58, 16, v61
  v_and_b32 v59, 0xffff0000, v61
  v_add_f32 v56, v56, v57
  v_add_f32 v58, v58, v59
  v_xor_b32 v58, v62, v58
  v_cvt_pk_bf16_f32 v16, v56, v58
  v_mul_f32 v56, v49, v33
  v_mul_f32 v57, v53, v41
  v_mul_f32 v58, v53, v37
  v_mul_f32 v59, v49, v45
  v_xor_b32 v57, v62, v57
  v_xor_b32 v57, 0x80000000, v57
  v_xor_b32 v59, v62, v59
  v_cvt_pk_bf16_f32 v60, v56, v57
  v_cvt_pk_bf16_f32 v61, v58, v59
  v_lshlrev_b32 v56, 16, v60
  v_and_b32 v57, 0xffff0000, v60
  v_lshlrev_b32 v58, 16, v61
  v_and_b32 v59, 0xffff0000, v61
  v_add_f32 v56, v56, v57
  v_add_f32 v58, v58, v59
  v_xor_b32 v58, v62, v58
  v_cvt_pk_bf16_f32 v17, v56, v58
  v_mul_f32 v56, v50, v34
  v_mul_f32 v57, v54, v42
  v_mul_f32 v58, v54, v38
  v_mul_f32 v59, v50, v46
  v_xor_b32 v57, v62, v57
  v_xor_b32 v57, 0x80000000, v57
  v_xor_b32 v59, v62, v59
  v_cvt_pk_bf16_f32 v60, v56, v57
  v_cvt_pk_bf16_f32 v61, v58, v59
  v_lshlrev_b32 v56, 16, v60
  v_and_b32 v57, 0xffff0000, v60
  v_lshlrev_b32 v58, 16, v61
  v_and_b32 v59, 0xffff0000, v61
  v_add_f32 v56, v56, v57
  v_add_f32 v58, v58, v59
  v_xor_b32 v58, v62, v58
  v_cvt_pk_bf16_f32 v18, v56, v58
  v_mul_f32 v56, v51, v35
  v_mul_f32 v57, v55, v43
  v_mul_f32 v58, v55, v39
  v_mul_f32 v59, v51, v47
  v_xor_b32 v57, v62, v57
  v_xor_b32 v57, 0x80000000, v57
  v_xor_b32 v59, v62, v59
  v_cvt_pk_bf16_f32 v60, v56, v57
  v_cvt_pk_bf16_f32 v61, v58, v59
  v_lshlrev_b32 v56, 16, v60
  v_and_b32 v57, 0xffff0000, v60
  v_lshlrev_b32 v58, 16, v61
  v_and_b32 v59, 0xffff0000, v61
  v_add_f32 v56, v56, v57
  v_add_f32 v58, v58, v59
  v_xor_b32 v58, v62, v58
  v_cvt_pk_bf16_f32 v19, v56, v58
  v_lshlrev_b32 v48, 16, v184
  v_and_b32 v49, 0xffff0000, v184
  v_lshlrev_b32 v50, 16, v185
  v_and_b32 v51, 0xffff0000, v185
  v_lshlrev_b32 v52, 16, v186
  v_and_b32 v53, 0xffff0000, v186
  v_lshlrev_b32 v54, 16, v187
  v_and_b32 v55, 0xffff0000, v187
  v_mul_f32 v56, v48, v32
  v_mul_f32 v57, v52, v40
  v_mul_f32 v58, v52, v36
  v_mul_f32 v59, v48, v44
  v_xor_b32 v57, v62, v57
  v_xor_b32 v57, 0x80000000, v57
  v_xor_b32 v59, v62, v59
  v_cvt_pk_bf16_f32 v60, v56, v57
  v_cvt_pk_bf16_f32 v61, v58, v59
  v_lshlrev_b32 v56, 16, v60
  v_and_b32 v57, 0xffff0000, v60
  v_lshlrev_b32 v58, 16, v61
  v_and_b32 v59, 0xffff0000, v61
  v_add_f32 v56, v56, v57
  v_add_f32 v58, v58, v59
  v_xor_b32 v58, v62, v58
  v_cvt_pk_bf16_f32 v26, v56, v58
  v_mul_f32 v56, v49, v33
  v_mul_f32 v57, v53, v41
  v_mul_f32 v58, v53, v37
  v_mul_f32 v59, v49, v45
  v_xor_b32 v57, v62, v57
  v_xor_b32 v57, 0x80000000, v57
  v_xor_b32 v59, v62, v59
  v_cvt_pk_bf16_f32 v60, v56, v57
  v_cvt_pk_bf16_f32 v61, v58, v59
  v_lshlrev_b32 v56, 16, v60
  v_and_b32 v57, 0xffff0000, v60
  v_lshlrev_b32 v58, 16, v61
  v_and_b32 v59, 0xffff0000, v61
  v_add_f32 v56, v56, v57
  v_add_f32 v58, v58, v59
  v_xor_b32 v58, v62, v58
  v_cvt_pk_bf16_f32 v27, v56, v58
  v_mul_f32 v56, v50, v34
  v_mul_f32 v57, v54, v42
  v_mul_f32 v58, v54, v38
  v_mul_f32 v59, v50, v46
  v_xor_b32 v57, v62, v57
  v_xor_b32 v57, 0x80000000, v57
  v_xor_b32 v59, v62, v59
  v_cvt_pk_bf16_f32 v60, v56, v57
  v_cvt_pk_bf16_f32 v61, v58, v59
  v_lshlrev_b32 v56, 16, v60
  v_and_b32 v57, 0xffff0000, v60
  v_lshlrev_b32 v58, 16, v61
  v_and_b32 v59, 0xffff0000, v61
  v_add_f32 v56, v56, v57
  v_add_f32 v58, v58, v59
  v_xor_b32 v58, v62, v58
  v_cvt_pk_bf16_f32 v28, v56, v58
  v_mul_f32 v56, v51, v35
  v_mul_f32 v57, v55, v43
  v_mul_f32 v58, v55, v39
  v_mul_f32 v59, v51, v47
  v_xor_b32 v57, v62, v57
  v_xor_b32 v57, 0x80000000, v57
  v_xor_b32 v59, v62, v59
  v_cvt_pk_bf16_f32 v60, v56, v57
  v_cvt_pk_bf16_f32 v61, v58, v59
  v_lshlrev_b32 v56, 16, v60
  v_and_b32 v57, 0xffff0000, v60
  v_lshlrev_b32 v58, 16, v61
  v_and_b32 v59, 0xffff0000, v61
  v_add_f32 v56, v56, v57
  v_add_f32 v58, v58, v59
  v_xor_b32 v58, v62, v58
  v_cvt_pk_bf16_f32 v29, v56, v58
  v_mov_b32 v10, 0
  v_mov_b32 v11, 0
  v_mov_b32 v12, 0
  v_mov_b32 v13, 0
  v_mov_b32 v14, 0xf149f2ca
  v_mov_b32 v15, 0
  v_mov_b32 v20, 0
  v_mov_b32 v21, 0
  v_mov_b32 v22, 0
  v_mov_b32 v23, 0
  v_mov_b32 v24, 0xf149f2ca
  v_mov_b32 v25, 0
  s_and_b32 s87, s89, 4
  s_cmp_eq_u32 s87, 0
  s_cselect_b32 s87, 4, 28
  s_add_u32 s89, s89, s87
  s_mov_b32 s75, 0
  s_mov_b32 s98, 0
  s_mov_b32 s99, 0
  s_barrier
  s_waitcnt vmcnt(12)
  s_nop 4
LA_loop:
  s_mov_b32 s38, s77
  s_mov_b32 s39, s78
  s_lshl_b32 s77, s73, 23
  s_lshl_b32 s87, s89, 12
  s_add_u32 s77, s77, s87
  s_add_u32 s78, s77, 0x400000
  s_lshl_b32 s79, s89, 11
  s_lshl_b32 s80, s73, 15
  s_lshl_b32 s87, s89, 4
  s_add_u32 s80, s80, s87
  s_add_u32 s81, s80, 0x4000
  s_cmp_lg_u32 s76, 0
  s_cselect_b32 s77, s77, 0x10000000
  s_cselect_b32 s78, s78, 0x10000000
  s_cselect_b32 s79, s79, 0x200000
  s_cselect_b32 s80, s80, 0
  s_cselect_b32 s81, s81, 0
  s_waitcnt vmcnt(9) lgkmcnt(0)
  v_mov_b32 v84, v100
  v_mov_b32 v85, v101
  v_mov_b32 v86, v102
  v_mov_b32 v87, v103
  v_mov_b32 v88, v104
  v_mov_b32 v89, v105
  v_mov_b32 v90, v106
  v_mov_b32 v91, v107
  v_mov_b32 v92, v108
  v_mov_b32 v93, v109
  v_mov_b32 v94, v110
  v_mov_b32 v95, v111
  v_mov_b32 v96, v112
  v_mov_b32 v97, v113
  v_mov_b32 v98, v114
  v_mov_b32 v99, v115
  v_mov_b32 v68, s40
  v_mov_b32 v69, s41
  v_mov_b32 v70, s44
  v_mov_b32 v71, s45
  v_mov_b32 v72, s48
  v_mov_b32 v73, s49
  v_mov_b32 v74, s52
  v_mov_b32 v75, s53
  v_mov_b32 v76, s56
  v_mov_b32 v77, s57
  v_mov_b32 v78, s60
  v_mov_b32 v79, s61
  v_mov_b32 v80, s64
  v_mov_b32 v81, s65
  v_mov_b32 v82, s68
  v_mov_b32 v83, s69
  s_mov_b32 exec_lo, 0
  v_mov_b32 v68, s42
  v_mov_b32 v69, s43
  v_mov_b32 v70, s46
  v_mov_b32 v71, s47
  v_mov_b32 v72, s50
  v_mov_b32 v73, s51
  v_mov_b32 v74, s54
  v_mov_b32 v75, s55
  v_mov_b32 v76, s58
  v_mov_b32 v77, s59
  v_mov_b32 v78, s62
  v_mov_b32 v79, s63
  v_mov_b32 v80, s66
  v_mov_b32 v81, s67
  v_mov_b32 v82, s70
  v_mov_b32 v83, s71
  s_mov_b32 exec_lo, -1
  s_load_dwordx4 s[40:43], s[24:25], s80
  s_load_dwordx4 s[44:47], s[26:27], s80
  s_load_dwordx4 s[48:51], s[28:29], s80
  s_load_dwordx4 s[52:55], s[30:31], s80
  s_load_dwordx4 s[56:59], s[24:25], s81
  s_load_dwordx4 s[60:63], s[26:27], s81
  s_load_dwordx4 s[64:67], s[28:29], s81
  s_load_dwordx4 s[68:71], s[30:31], s81
  s_cmp_eq_u32 s75, 8
  s_cbranch_scc0 LA_nofl
  s_mov_b64 exec, 1
  global_load_dword v8, v6, s[32:33] sc1
  s_mov_b64 exec, -1
  s_branch LA_notk
LA_nofl:
  s_cmp_eq_u32 s75, 9
  s_cbranch_scc0 LA_nofl2
  v_readfirstlane_b32 s90, v8
  s_mov_b32 s91, 0x40000
LA_poll:
  s_cmp_lg_u32 s90, 0
  s_cbranch_scc1 LA_nofl2
  s_sub_u32 s91, s91, 1
  s_cmp_eq_u32 s91, 0
  s_cbranch_scc1 LA_nofl2
  s_sleep 8
  s_mov_b64 exec, 1
  global_load_dword v8, v6, s[32:33] sc1
  s_waitcnt vmcnt(0)
  s_mov_b64 exec, -1
  v_readfirstlane_b32 s90, v8
  s_branch LA_poll
LA_nofl2:
  s_cmp_lg_u32 s74, 0
  s_cbranch_scc1 LA_notk
  s_cmp_eq_u32 s75, 28
  s_cbranch_scc0 LA_nork
  s_mov_b32 s100, 1
  s_atomic_add s100, s[36:37], 0x0 glc
  s_branch LA_notk
LA_nork:
  s_cmp_eq_u32 s75, 29
  s_cbranch_scc0 LA_notk
  s_add_u32 s87, s100, 1
  v_mov_b32 v64, s87
  v_mov_b32 v9, 24576
  s_mov_b64 exec, 1
  ds_write_b32 v9, v64
  s_mov_b64 exec, -1
LA_notk:
  s_nop 1
  v_lshlrev_b32 v30, 16, v68
  v_and_b32 v31, 0xffff0000, v68
  v_perm_b32 v36, v86, v84, s84
  v_perm_b32 v37, v86, v84, s85
  v_perm_b32 v38, v87, v85, s84
  v_perm_b32 v39, v87, v85, s85
  v_dot2_f32_bf16 v32, v36, v16, 0
  v_dot2_f32_bf16 v33, v37, v17, 0
  v_dot2_f32_bf16 v34, v38, v18, 0
  v_dot2_f32_bf16 v35, v39, v19, 0
  s_waitcnt vmcnt(14)
  v_cvt_f32_i32 v116, v116
  v_cvt_f32_i32 v117, v117
  v_cvt_f32_i32 v118, v118
  v_cvt_f32_i32 v119, v119
  v_pk_add_f32 v[116:117], v[116:117], v[30:31] op_sel:[0,0] op_sel_hi:[1,0] neg_lo:[0,1] neg_hi:[0,1]
  v_pk_add_f32 v[118:119], v[118:119], v[30:31] op_sel:[0,0] op_sel_hi:[1,0] neg_lo:[0,1] neg_hi:[0,1]
  v_pk_mul_f32 v[40:41], v[116:117], v[32:33]
  v_pk_fma_f32 v[40:41], v[118:119], v[34:35], v[40:41]
  buffer_load_dwordx2 v[100:101], v2, s[12:15], s79 offen offset:0
  buffer_load_dwordx4 v[164:167], v1, s[8:11], s39 offen offset:0 nt
  v_add_f32 v42, v40, v41
  v_perm_b32 v36, v90, v88, s84
  v_perm_b32 v37, v90, v88, s85
  v_perm_b32 v38, v91, v89, s84
  v_perm_b32 v39, v91, v89, s85
  v_dot2_f32_bf16 v32, v36, v16, 0
  v_dot2_f32_bf16 v33, v37, v17, 0
  v_dot2_f32_bf16 v34, v38, v18, 0
  v_dot2_f32_bf16 v35, v39, v19, 0
  s_waitcnt vmcnt(14)
  v_cvt_f32_i32 v120, v120
  v_cvt_f32_i32 v121, v121
  v_cvt_f32_i32 v122, v122
  v_cvt_f32_i32 v123, v123
  v_pk_add_f32 v[120:121], v[120:121], v[30:31] op_sel:[0,1] op_sel_hi:[1,1] neg_lo:[0,1] neg_hi:[0,1]
  v_pk_add_f32 v[122:123], v[122:123], v[30:31] op_sel:[0,1] op_sel_hi:[1,1] neg_lo:[0,1] neg_hi:[0,1]
  v_pk_mul_f32 v[40:41], v[120:121], v[32:33]
  v_pk_fma_f32 v[40:41], v[122:123], v[34:35], v[40:41]
  buffer_load_dwordx2 v[102:103], v3, s[16:19], s79 offen offset:0
  buffer_load_dwordx4 v[168:171], v1, s[8:11], s39 offen offset:512 nt
  v_add_f32 v43, v40, v41
  v_lshlrev_b32 v30, 16, v69
  v_and_b32 v31, 0xffff0000, v69
  v_perm_b32 v36, v94, v92, s84
  v_perm_b32 v37, v94, v92, s85
  v_perm_b32 v38, v95, v93, s84
  v_perm_b32 v39, v95, v93, s85
  v_dot2_f32_bf16 v32, v36, v16, 0
  v_dot2_f32_bf16 v33, v37, v17, 0
  v_dot2_f32_bf16 v34, v38, v18, 0
  v_dot2_f32_bf16 v35, v39, v19, 0
  s_waitcnt vmcnt(14)
  v_cvt_f32_i32 v124, v124
  v_cvt_f32_i32 v125, v125
  v_cvt_f32_i32 v126, v126
  v_cvt_f32_i32 v127, v127
  v_pk_add_f32 v[124:125], v[124:125], v[30:31] op_sel:[0,0] op_sel_hi:[1,0] neg_lo:[0,1] neg_hi:[0,1]
  v_pk_add_f32 v[126:127], v[126:127], v[30:31] op_sel:[0,0] op_sel_hi:[1,0] neg_lo:[0,1] neg_hi:[0,1]
  v_pk_mul_f32 v[40:41], v[124:125], v[32:33]
  v_pk_fma_f32 v[40:41], v[126:127], v[34:35], v[40:41]
  buffer_load_dwordx2 v[104:105], v2, s[12:15], s79 offen offset:256
  buffer_load_dwordx4 v[172:175], v1, s[8:11], s39 offen offset:1024 nt
  v_add_f32 v44, v40, v41
  v_perm_b32 v36, v98, v96, s84
  v_perm_b32 v37, v98, v96, s85
  v_perm_b32 v38, v99, v97, s84
  v_perm_b32 v39, v99, v97, s85
  v_dot2_f32_bf16 v32, v36, v16, 0
  v_dot2_f32_bf16 v33, v37, v17, 0
  v_dot2_f32_bf16 v34, v38, v18, 0
  v_dot2_f32_bf16 v35, v39, v19, 0
  s_waitcnt vmcnt(14)
  v_cvt_f32_i32 v128, v128
  v_cvt_f32_i32 v129, v129
  v_cvt_f32_i32 v130, v130
  v_cvt_f32_i32 v131, v131
  v_pk_add_f32 v[128:129], v[128:129], v[30:31] op_sel:[0,1] op_sel_hi:[1,1] neg_lo:[0,1] neg_hi:[0,1]
  v_pk_add_f32 v[130:131], v[130:131], v[30:31] op_sel:[0,1] op_sel_hi:[1,1] neg_lo:[0,1] neg_hi:[0,1]
  v_pk_mul_f32 v[40:41], v[128:129], v[32:33]
  v_pk_fma_f32 v[40:41], v[130:131], v[34:35], v[40:41]
  buffer_load_dwordx2 v[106:107], v3, s[16:19], s79 offen offset:256
  buffer_load_dwordx4 v[176:179], v1, s[8:11], s39 offen offset:1536 nt
  v_add_f32 v45, v40, v41
  v_lshlrev_b32 v30, 16, v76
  v_and_b32 v31, 0xffff0000, v76
  v_perm_b32 v36, v86, v84, s84
  v_perm_b32 v37, v86, v84, s85
  v_perm_b32 v38, v87, v85, s84
  v_perm_b32 v39, v87, v85, s85
  v_dot2_f32_bf16 v32, v36, v26, 0
  v_dot2_f32_bf16 v33, v37, v27, 0
  v_dot2_f32_bf16 v34, v38, v28, 0
  v_dot2_f32_bf16 v35, v39, v29, 0
  s_waitcnt vmcnt(15)
  v_cvt_f32_i32 v132, v132
  v_cvt_f32_i32 v133, v133
  v_cvt_f32_i32 v134, v134
  v_cvt_f32_i32 v135, v135
  v_pk_add_f32 v[132:133], v[132:133], v[30:31] op_sel:[0,0] op_sel_hi:[1,0] neg_lo:[0,1] neg_hi:[0,1]
  v_pk_add_f32 v[134:135], v[134:135], v[30:31] op_sel:[0,0] op_sel_hi:[1,0] neg_lo:[0,1] neg_hi:[0,1]
  v_pk_mul_f32 v[40:41], v[132:133], v[32:33]
  v_pk_fma_f32 v[40:41], v[134:135], v[34:35], v[40:41]
  buffer_load_dwordx2 v[108:109], v2, s[12:15], s79 offen offset:512
  buffer_load_dwordx4 v[116:119], v1, s[4:7], s77 offen offset:0 nt
  v_add_f32 v46, v40, v41
  v_perm_b32 v36, v90, v88, s84
  v_perm_b32 v37, v90, v88, s85
  v_perm_b32 v38, v91, v89, s84
  v_perm_b32 v39, v91, v89, s85
  v_dot2_f32_bf16 v32, v36, v26, 0
  v_dot2_f32_bf16 v33, v37, v27, 0
  v_dot2_f32_bf16 v34, v38, v28, 0
  v_dot2_f32_bf16 v35, v39, v29, 0
  s_waitcnt vmcnt(16)
  v_cvt_f32_i32 v136, v136
  v_cvt_f32_i32 v137, v137
  v_cvt_f32_i32 v138, v138
  v_cvt_f32_i32 v139, v139
  v_pk_add_f32 v[136:137], v[136:137], v[30:31] op_sel:[0,1] op_sel_hi:[1,1] neg_lo:[0,1] neg_hi:[0,1]
  v_pk_add_f32 v[138:139], v[138:139], v[30:31] op_sel:[0,1] op_sel_hi:[1,1] neg_lo:[0,1] neg_hi:[0,1]
  v_pk_mul_f32 v[40:41], v[136:137], v[32:33]
  v_pk_fma_f32 v[40:41], v[138:139], v[34:35], v[40:41]
  buffer_load_dwordx2 v[110:111], v3, s[16:19], s79 offen offset:512
  buffer_load_dwordx4 v[120:123], v1, s[4:7], s77 offen offset:512 nt
  v_add_f32 v47, v40, v41
  v_lshlrev_b32 v30, 16, v77
  v_and_b32 v31, 0xffff0000, v77
  v_perm_b32 v36, v94, v92, s84
  v_perm_b32 v37, v94, v92, s85
  v_perm_b32 v38, v95, v93, s84
  v_perm_b32 v39, v95, v93, s85
  v_dot2_f32_bf16 v32, v36, v26, 0
  v_dot2_f32_bf16 v33, v37, v27, 0
  v_dot2_f32_bf16 v34, v38, v28, 0
  v_dot2_f32_bf16 v35, v39, v29, 0
  s_waitcnt vmcnt(17)
  v_cvt_f32_i32 v140, v140
  v_cvt_f32_i32 v141, v141
  v_cvt_f32_i32 v142, v142
  v_cvt_f32_i32 v143, v143
  v_pk_add_f32 v[140:141], v[140:141], v[30:31] op_sel:[0,0] op_sel_hi:[1,0] neg_lo:[0,1] neg_hi:[0,1]
  v_pk_add_f32 v[142:143], v[142:143], v[30:31] op_sel:[0,0] op_sel_hi:[1,0] neg_lo:[0,1] neg_hi:[0,1]
  v_pk_mul_f32 v[40:41], v[140:141], v[32:33]
  v_pk_fma_f32 v[40:41], v[142:143], v[34:35], v[40:41]
  buffer_load_dwordx2 v[112:113], v2, s[12:15], s79 offen offset:768
  buffer_load_dwordx4 v[124:127], v1, s[4:7], s77 offen offset:1024 nt
  v_add_f32 v48, v40, v41
  v_perm_b32 v36, v98, v96, s84
  v_perm_b32 v37, v98, v96, s85
  v_perm_b32 v38, v99, v97, s84
  v_perm_b32 v39, v99, v97, s85
  v_dot2_f32_bf16 v32, v36, v26, 0
  v_dot2_f32_bf16 v33, v37, v27, 0
  v_dot2_f32_bf16 v34, v38, v28, 0
  v_dot2_f32_bf16 v35, v39, v29, 0
  s_waitcnt vmcnt(18)
  v_cvt_f32_i32 v144, v144
  v_cvt_f32_i32 v145, v145
  v_cvt_f32_i32 v146, v146
  v_cvt_f32_i32 v147, v147
  v_pk_add_f32 v[144:145], v[144:145], v[30:31] op_sel:[0,1] op_sel_hi:[1,1] neg_lo:[0,1] neg_hi:[0,1]
  v_pk_add_f32 v[146:147], v[146:147], v[30:31] op_sel:[0,1] op_sel_hi:[1,1] neg_lo:[0,1] neg_hi:[0,1]
  v_pk_mul_f32 v[40:41], v[144:145], v[32:33]
  v_pk_fma_f32 v[40:41], v[146:147], v[34:35], v[40:41]
  buffer_load_dwordx2 v[114:115], v3, s[16:19], s79 offen offset:768
  buffer_load_dwordx4 v[128:131], v1, s[4:7], s77 offen offset:1536 nt
  v_add_f32 v49, v40, v41
  v_permlane16_swap_b32 v42, v43
  v_permlane16_swap_b32 v44, v45
  v_permlane16_swap_b32 v46, v47
  v_permlane16_swap_b32 v48, v49
  v_add_f32 v42, v42, v43
  v_add_f32 v44, v44, v45
  v_add_f32 v46, v46, v47
  v_add_f32 v48, v48, v49
  v_add_f32_dpp v42, v42, v42 quad_perm:[1,0,3,2] row_mask:0xf bank_mask:0xf
  v_add_f32_dpp v44, v44, v44 quad_perm:[1,0,3,2] row_mask:0xf bank_mask:0xf
  v_add_f32_dpp v46, v46, v46 quad_perm:[1,0,3,2] row_mask:0xf bank_mask:0xf
  v_add_f32_dpp v48, v48, v48 quad_perm:[1,0,3,2] row_mask:0xf bank_mask:0xf
  v_add_f32_dpp v42, v42, v42 quad_perm:[2,3,0,1] row_mask:0xf bank_mask:0xf
  v_add_f32_dpp v44, v44, v44 quad_perm:[2,3,0,1] row_mask:0xf bank_mask:0xf
  v_add_f32_dpp v46, v46, v46 quad_perm:[2,3,0,1] row_mask:0xf bank_mask:0xf
  v_add_f32_dpp v48, v48, v48 quad_perm:[2,3,0,1] row_mask:0xf bank_mask:0xf
  v_add_f32_dpp v42, v42, v42 row_half_mirror row_mask:0xf bank_mask:0xf
  v_add_f32_dpp v44, v44, v44 row_half_mirror row_mask:0xf bank_mask:0xf
  v_add_f32_dpp v46, v46, v46 row_half_mirror row_mask:0xf bank_mask:0xf
  v_add_f32_dpp v48, v48, v48 row_half_mirror row_mask:0xf bank_mask:0xf
  v_add_f32_dpp v42, v42, v42 row_mirror row_mask:0xf bank_mask:0xf
  v_add_f32_dpp v44, v44, v44 row_mirror row_mask:0xf bank_mask:0xf
  v_add_f32_dpp v46, v46, v46 row_mirror row_mask:0xf bank_mask:0xf
  v_add_f32_dpp v48, v48, v48 row_mirror row_mask:0xf bank_mask:0xf
  v_perm_b32 v43, v70, v70, v5
  v_perm_b32 v45, v71, v71, v5
  v_perm_b32 v47, v78, v78, v5
  v_perm_b32 v49, v79, v79, v5
  v_mul_f32 v42, v42, v43
  v_mul_f32 v44, v44, v45
  v_mul_f32 v46, v46, v47
  v_mul_f32 v48, v48, v49
  v_max3_f32 v62, v42, v44, v14
  v_max3_f32 v63, v46, v48, v24
  v_mov_b32 v64, v62
  v_mov_b32 v65, v63
  s_nop 0
  v_permlane16_swap_b32 v62, v64
  v_permlane16_swap_b32 v63, v65
  v_max_f32 v62, v62, v64
  v_max_f32 v63, v63, v65
  v_mul_f32 v66, s86, v62
  v_mul_f32 v67, s86, v63
  v_fma_f32 v58, v14, s86, -v66
  v_fma_f32 v60, v24, s86, -v67
  v_fma_f32 v42, v42, s86, -v66
  v_fma_f32 v44, v44, s86, -v66
  v_fma_f32 v46, v46, s86, -v67
  v_fma_f32 v48, v48, s86, -v67
  v_exp_f32 v58, v58
  v_exp_f32 v60, v60
  v_exp_f32 v42, v42
  v_exp_f32 v44, v44
  v_exp_f32 v46, v46
  v_exp_f32 v48, v48
  v_mov_b32 v14, v62
  v_mov_b32 v24, v63
  v_perm_b32 v43, v72, v72, v5
  v_perm_b32 v45, v73, v73, v5
  v_perm_b32 v47, v80, v80, v5
  v_perm_b32 v49, v81, v81, v5
  v_add_f32 v64, v42, v44
  v_add_f32 v65, v46, v48
  v_mul_f32 v50, v42, v43
  v_mul_f32 v52, v44, v45
  v_mul_f32 v54, v46, v47
  v_mul_f32 v56, v48, v49
  v_fma_f32 v15, v15, v58, v64
  v_fma_f32 v25, v25, v60, v65
  v_mov_b32 v51, v50
  v_mov_b32 v53, v52
  v_mov_b32 v55, v54
  v_mov_b32 v57, v56
  v_pk_mul_f32 v[10:11], v[10:11], v[58:59] op_sel_hi:[1,0]
  v_pk_mul_f32 v[12:13], v[12:13], v[58:59] op_sel_hi:[1,0]
  v_pk_mul_f32 v[20:21], v[20:21], v[60:61] op_sel_hi:[1,0]
  v_pk_mul_f32 v[22:23], v[22:23], v[60:61] op_sel_hi:[1,0]
  v_permlane16_swap_b32 v50, v51
  v_permlane16_swap_b32 v52, v53
  v_permlane16_swap_b32 v54, v55
  v_permlane16_swap_b32 v56, v57
  v_lshlrev_b32 v30, 16, v74
  v_and_b32 v31, 0xffff0000, v74
  s_waitcnt vmcnt(19)
  v_cvt_f32_i32 v148, v148
  v_cvt_f32_i32 v149, v149
  v_cvt_f32_i32 v150, v150
  v_cvt_f32_i32 v151, v151
  v_pk_add_f32 v[148:149], v[148:149], v[30:31] op_sel:[0,0] op_sel_hi:[1,0] neg_lo:[0,1] neg_hi:[0,1]
  v_pk_add_f32 v[150:151], v[150:151], v[30:31] op_sel:[0,0] op_sel_hi:[1,0] neg_lo:[0,1] neg_hi:[0,1]
  v_pk_fma_f32 v[10:11], v[148:149], v[50:51], v[10:11] op_sel:[0,0,0] op_sel_hi:[1,0,1]
  v_pk_fma_f32 v[12:13], v[150:151], v[50:51], v[12:13] op_sel:[0,0,0] op_sel_hi:[1,0,1]
  buffer_load_dwordx4 v[132:135], v1, s[4:7], s78 offen offset:0 nt
  s_waitcnt vmcnt(19)
  v_cvt_f32_i32 v152, v152
  v_cvt_f32_i32 v153, v153
  v_cvt_f32_i32 v154, v154
  v_cvt_f32_i32 v155, v155
  v_pk_add_f32 v[152:153], v[152:153], v[30:31] op_sel:[0,1] op_sel_hi:[1,1] neg_lo:[0,1] neg_hi:[0,1]
  v_pk_add_f32 v[154:155], v[154:155], v[30:31] op_sel:[0,1] op_sel_hi:[1,1] neg_lo:[0,1] neg_hi:[0,1]
  v_pk_fma_f32 v[10:11], v[152:153], v[50:51], v[10:11] op_sel:[0,1,0] op_sel_hi:[1,1,1]
  v_pk_fma_f32 v[12:13], v[154:155], v[50:51], v[12:13] op_sel:[0,1,0] op_sel_hi:[1,1,1]
  buffer_load_dwordx4 v[136:139], v1, s[4:7], s78 offen offset:512 nt
  v_lshlrev_b32 v30, 16, v75
  v_and_b32 v31, 0xffff0000, v75
  s_waitcnt vmcnt(19)
  v_cvt_f32_i32 v156, v156
  v_cvt_f32_i32 v157, v157
  v_cvt_f32_i32 v158, v158
  v_cvt_f32_i32 v159, v159
  v_pk_add_f32 v[156:157], v[156:157], v[30:31] op_sel:[0,0] op_sel_hi:[1,0] neg_lo:[0,1] neg_hi:[0,1]
  v_pk_add_f32 v[158:159], v[158:159], v[30:31] op_sel:[0,0] op_sel_hi:[1,0] neg_lo:[0,1] neg_hi:[0,1]
  v_pk_fma_f32 v[10:11], v[156:157], v[52:53], v[10:11] op_sel:[0,0,0] op_sel_hi:[1,0,1]
  v_pk_fma_f32 v[12:13], v[158:159], v[52:53], v[12:13] op_sel:[0,0,0] op_sel_hi:[1,0,1]
  buffer_load_dwordx4 v[140:143], v1, s[4:7], s78 offen offset:1024 nt
  s_waitcnt vmcnt(19)
  v_cvt_f32_i32 v160, v160
  v_cvt_f32_i32 v161, v161
  v_cvt_f32_i32 v162, v162
  v_cvt_f32_i32 v163, v163
  v_pk_add_f32 v[160:161], v[160:161], v[30:31] op_sel:[0,1] op_sel_hi:[1,1] neg_lo:[0,1] neg_hi:[0,1]
  v_pk_add_f32 v[162:163], v[162:163], v[30:31] op_sel:[0,1] op_sel_hi:[1,1] neg_lo:[0,1] neg_hi:[0,1]
  v_pk_fma_f32 v[10:11], v[160:161], v[52:53], v[10:11] op_sel:[0,1,0] op_sel_hi:[1,1,1]
  v_pk_fma_f32 v[12:13], v[162:163], v[52:53], v[12:13] op_sel:[0,1,0] op_sel_hi:[1,1,1]
  buffer_load_dwordx4 v[144:147], v1, s[4:7], s78 offen offset:1536 nt
  v_lshlrev_b32 v30, 16, v82
  v_and_b32 v31, 0xffff0000, v82
  s_waitcnt vmcnt(18)
  v_cvt_f32_i32 v164, v164
  v_cvt_f32_i32 v165, v165
  v_cvt_f32_i32 v166, v166
  v_cvt_f32_i32 v167, v167
  v_pk_add_f32 v[164:165], v[164:165], v[30:31] op_sel:[0,0] op_sel_hi:[1,0] neg_lo:[0,1] neg_hi:[0,1]
  v_pk_add_f32 v[166:167], v[166:167], v[30:31] op_sel:[0,0] op_sel_hi:[1,0] neg_lo:[0,1] neg_hi:[0,1]
  v_pk_fma_f32 v[20:21], v[164:165], v[54:55], v[20:21] op_sel:[0,0,0] op_sel_hi:[1,0,1]
  v_pk_fma_f32 v[22:23], v[166:167], v[54:55], v[22:23] op_sel:[0,0,0] op_sel_hi:[1,0,1]
  buffer_load_dwordx4 v[148:151], v1, s[8:11], s77 offen offset:0 nt
  s_waitcnt vmcnt(17)
  v_cvt_f32_i32 v168, v168
  v_cvt_f32_i32 v169, v169
  v_cvt_f32_i32 v170, v170
  v_cvt_f32_i32 v171, v171
  v_pk_add_f32 v[168:169], v[168:169], v[30:31] op_sel:[0,1] op_sel_hi:[1,1] neg_lo:[0,1] neg_hi:[0,1]
  v_pk_add_f32 v[170:171], v[170:171], v[30:31] op_sel:[0,1] op_sel_hi:[1,1] neg_lo:[0,1] neg_hi:[0,1]
  v_pk_fma_f32 v[20:21], v[168:169], v[54:55], v[20:21] op_sel:[0,1,0] op_sel_hi:[1,1,1]
  v_pk_fma_f32 v[22:23], v[170:171], v[54:55], v[22:23] op_sel:[0,1,0] op_sel_hi:[1,1,1]
  buffer_load_dwordx4 v[152:155], v1, s[8:11], s77 offen offset:512 nt
  v_lshlrev_b32 v30, 16, v83
  v_and_b32 v31, 0xffff0000, v83
  s_waitcnt vmcnt(16)
  v_cvt_f32_i32 v172, v172
  v_cvt_f32_i32 v173, v173
  v_cvt_f32_i32 v174, v174
  v_cvt_f32_i32 v175, v175
  v_pk_add_f32 v[172:173], v[172:173], v[30:31] op_sel:[0,0] op_sel_hi:[1,0] neg_lo:[0,1] neg_hi:[0,1]
  v_pk_add_f32 v[174:175], v[174:175], v[30:31] op_sel:[0,0] op_sel_hi:[1,0] neg_lo:[0,1] neg_hi:[0,1]
  v_pk_fma_f32 v[20:21], v[172:173], v[56:57], v[20:21] op_sel:[0,0,0] op_sel_hi:[1,0,1]
  v_pk_fma_f32 v[22:23], v[174:175], v[56:57], v[22:23] op_sel:[0,0,0] op_sel_hi:[1,0,1]
  buffer_load_dwordx4 v[156:159], v1, s[8:11], s77 offen offset:1024 nt
  s_waitcnt vmcnt(15)
  v_cvt_f32_i32 v176, v176
  v_cvt_f32_i32 v177, v177
  v_cvt_f32_i32 v178, v178
  v_cvt_f32_i32 v179, v179
  v_pk_add_f32 v[176:177], v[176:177], v[30:31] op_sel:[0,1] op_sel_hi:[1,1] neg_lo:[0,1] neg_hi:[0,1]
  v_pk_add_f32 v[178:179], v[178:179], v[30:31] op_sel:[0,1] op_sel_hi:[1,1] neg_lo:[0,1] neg_hi:[0,1]
  v_pk_fma_f32 v[20:21], v[176:177], v[56:57], v[20:21] op_sel:[0,1,0] op_sel_hi:[1,1,1]
  v_pk_fma_f32 v[22:23], v[178:179], v[56:57], v[22:23] op_sel:[0,1,0] op_sel_hi:[1,1,1]
  buffer_load_dwordx4 v[160:163], v1, s[8:11], s77 offen offset:1536 nt
  s_add_u32 s88, s75, 2
  s_cmp_ge_u32 s88, 31
  s_cbranch_scc1 LA_dyn
  s_and_b32 s87, s89, 4
  s_cmp_eq_u32 s87, 0
  s_cselect_b32 s87, 4, 28
  s_add_u32 s82, s89, s87
  s_mov_b32 s83, 1
  s_branch LA_adv
LA_dyn:
  s_mov_b32 s83, 0
  s_mov_b32 s82, 0
  s_cmp_eq_u32 s76, 0
  s_cbranch_scc1 LA_adv
  s_cmp_eq_u32 s88, 31
  s_cbranch_scc0 LA_haverk
  v_mov_b32 v9, 24576
  s_mov_b32 s91, 0x100000
LA_mbx:
  ds_read_b32 v64, v9
  s_waitcnt lgkmcnt(0)
  v_readfirstlane_b32 s100, v64
  s_nop 0
  s_cmp_lg_u32 s100, 0
  s_cbranch_scc1 LA_mbx_ok
  s_sub_u32 s91, s91, 1
  s_cmp_eq_u32 s91, 0
  s_cbranch_scc1 LA_adv
  s_sleep 1
  s_branch LA_mbx
LA_mbx_ok:
  s_sub_u32 s100, s100, 1
  s_and_b32 s100, s100, 7
  s_lshl_b32 s87, s100, 3
  s_mov_b32 s100, 0x4040808
  s_mov_b32 s101, 0x404
  s_lshr_b64 s[100:101], s[100:101], s87
  s_and_b32 s98, s100, 0xff
  s_mov_b32 s100, 0x14100800
  s_mov_b32 s101, 0x20201c18
  s_lshr_b64 s[100:101], s[100:101], s87
  s_and_b32 s99, s100, 0xff
LA_haverk:
  s_sub_u32 s87, s88, 31
  s_lshl_b32 s87, s87, 2
  s_add_u32 s87, s87, s74
  s_cmp_lt_u32 s87, s98
  s_cselect_b32 s83, 1, 0
  s_add_u32 s87, s87, s99
  s_lshr_b32 s82, s87, 4
  s_lshl_b32 s82, s82, 9
  s_lshr_b32 s88, s87, 2
  s_and_b32 s88, s88, 3
  s_lshl_b32 s88, s88, 3
  s_add_u32 s82, s82, s88
  s_and_b32 s87, s87, 3
  s_add_u32 s82, s82, s87
  s_add_u32 s82, s82, 484
  s_and_b32 s82, s82, 1023
LA_adv:
  s_mov_b32 s87, s76
  s_mov_b32 s89, s82
  s_mov_b32 s76, s83
  s_add_u32 s75, s75, 1
  s_cmp_lt_u32 s75, 300
  s_cselect_b32 s87, s87, 0
  s_cmp_lg_u32 s87, 0
  s_nop 2
  s_cbranch_scc1 LA_loop
  v_mov_b32 v64, v15
  s_nop 1
  v_permlane16_swap_b32 v15, v64
  v_add_f32 v15, v15, v64
  v_mov_b32 v64, v25
  s_nop 1
  v_permlane16_swap_b32 v25, v64
  v_add_f32 v25, v25, v64
  v_lshlrev_b32 v30, 4, v0
  v_lshlrev_b32 v31, 3, v0
  ds_write_b128 v30, v[10:13]
  ds_write_b128 v30, v[20:23] offset:4096
  ds_write_b64 v31, v[14:15] offset:8192
  ds_write_b64 v31, v[24:25] offset:10240
  s_waitcnt lgkmcnt(0)
  s_barrier
  v_lshrrev_b32 v32, 7, v0
  v_and_b32 v33, 127, v0
  v_mul_u32_u24 v34, 4096, v32
  v_lshl_add_u32 v34, v33, 2, v34
  v_mul_u32_u24 v35, 2048, v32
  ds_read_b32 v40, v34 offset:0
  ds_read_b64 v[48:49], v35 offset:8192
  ds_read_b32 v41, v34 offset:512
  ds_read_b64 v[50:51], v35 offset:8448
  ds_read_b32 v42, v34 offset:1024
  ds_read_b64 v[52:53], v35 offset:8704
  ds_read_b32 v43, v34 offset:1536
  ds_read_b64 v[54:55], v35 offset:8960
  ds_read_b32 v44, v34 offset:2048
  ds_read_b64 v[56:57], v35 offset:9216
  ds_read_b32 v45, v34 offset:2560
  ds_read_b64 v[58:59], v35 offset:9472
  s_waitcnt lgkmcnt(4)
  ds_read_b32 v46, v34 offset:3072
  ds_read_b64 v[60:61], v35 offset:9728
  ds_read_b32 v47, v34 offset:3584
  ds_read_b64 v[62:63], v35 offset:9984
  v_mov_b32 v69, s90
  s_waitcnt lgkmcnt(0)
  v_max3_f32 v36, v48, v50, v52
  v_max3_f32 v36, v36, v54, v56
  v_max3_f32 v36, v36, v58, v60
  v_max_f32 v36, v36, v62
  v_mul_f32 v37, s86, v36
  v_fma_f32 v48, v48, s86, -v37
  v_fma_f32 v50, v50, s86, -v37
  v_fma_f32 v52, v52, s86, -v37
  v_fma_f32 v54, v54, s86, -v37
  v_fma_f32 v56, v56, s86, -v37
  v_fma_f32 v58, v58, s86, -v37
  v_fma_f32 v60, v60, s86, -v37
  v_fma_f32 v62, v62, s86, -v37
  v_exp_f32 v48, v48
  v_exp_f32 v50, v50
  v_exp_f32 v52, v52
  v_exp_f32 v54, v54
  v_exp_f32 v56, v56
  v_exp_f32 v58, v58
  v_exp_f32 v60, v60
  v_exp_f32 v62, v62
  v_mul_f32 v68, v40, v48
  v_mul_f32 v39, v49, v48
  v_fmac_f32 v68, v41, v50
  v_fmac_f32 v39, v51, v50
  v_fmac_f32 v68, v42, v52
  v_fmac_f32 v39, v53, v52
  v_fmac_f32 v68, v43, v54
  v_fmac_f32 v39, v55, v54
  v_fmac_f32 v68, v44, v56
  v_fmac_f32 v39, v57, v56
  v_fmac_f32 v68, v45, v58
  v_fmac_f32 v39, v59, v58
  v_fmac_f32 v68, v46, v60
  v_fmac_f32 v39, v61, v60
  v_fmac_f32 v68, v47, v62
  v_fmac_f32 v39, v63, v62
  s_lshl_b32 s87, s73, 4
  s_add_u32 s87, s87, s72
  s_lshl_b32 s87, s87, 11
  v_lshlrev_b32 v34, 14, v32
  v_lshl_add_u32 v35, v33, 3, v34
  buffer_store_dwordx2 v[68:69], v35, s[20:23], s87 offen sc1
  v_mov_b32 v40, v36
  v_mov_b32 v41, v69
  v_mov_b32 v42, v39
  v_mov_b32 v43, v69
  v_cmp_eq_u32 vcc, 0, v33
  s_nop 0
  s_and_saveexec_b64 s[58:59], vcc
  s_cbranch_execz LA_nost
  buffer_store_dwordx4 v[40:43], v34, s[20:23], s87 offen offset:1024 sc1
LA_nost:
  s_mov_b64 exec, s[58:59]
  s_add_u32 s88, s73, 3
  s_and_b32 s88, s88, 7
  s_cmp_lg_u32 s88, s72
  s_cbranch_scc1 LA_fin
  s_lshl_b32 s87, s73, 15
  s_add_u32 s88, s87, 4096
  s_add_u32 s60, s87, 8192
  s_add_u32 s61, s87, 12288
  s_mov_b32 s62, 0x40000
LA_cpoll:
  buffer_load_dwordx2 v[100:101], v35, s[20:23], s87 offen offset:0 sc1
  buffer_load_dwordx4 v[116:119], v34, s[20:23], s87 offen offset:1024 sc1
  buffer_load_dwordx2 v[102:103], v35, s[20:23], s87 offen offset:2048 sc1
  buffer_load_dwordx4 v[120:123], v34, s[20:23], s87 offen offset:3072 sc1
  buffer_load_dwordx2 v[104:105], v35, s[20:23], s88 offen offset:0 sc1
  buffer_load_dwordx4 v[124:127], v34, s[20:23], s88 offen offset:1024 sc1
  buffer_load_dwordx2 v[106:107], v35, s[20:23], s88 offen offset:2048 sc1
  buffer_load_dwordx4 v[128:131], v34, s[20:23], s88 offen offset:3072 sc1
  buffer_load_dwordx2 v[108:109], v35, s[20:23], s60 offen offset:0 sc1
  buffer_load_dwordx4 v[132:135], v34, s[20:23], s60 offen offset:1024 sc1
  buffer_load_dwordx2 v[110:111], v35, s[20:23], s60 offen offset:2048 sc1
  buffer_load_dwordx4 v[136:139], v34, s[20:23], s60 offen offset:3072 sc1
  buffer_load_dwordx2 v[112:113], v35, s[20:23], s61 offen offset:0 sc1
  buffer_load_dwordx4 v[140:143], v34, s[20:23], s61 offen offset:1024 sc1
  buffer_load_dwordx2 v[114:115], v35, s[20:23], s61 offen offset:2048 sc1
  buffer_load_dwordx4 v[144:147], v34, s[20:23], s61 offen offset:3072 sc1
  s_waitcnt vmcnt(0)
  v_xor_b32 v70, v101, v69
  v_xor_b32 v71, v117, v69
  v_xor_b32 v72, v119, v69
  v_or3_b32 v70, v70, v71, v72
  v_xor_b32 v71, v103, v69
  v_or_b32 v70, v70, v71
  v_xor_b32 v71, v121, v69
  v_xor_b32 v72, v123, v69
  v_or3_b32 v70, v70, v71, v72
  v_xor_b32 v71, v105, v69
  v_or_b32 v70, v70, v71
  v_xor_b32 v71, v125, v69
  v_xor_b32 v72, v127, v69
  v_or3_b32 v70, v70, v71, v72
  v_xor_b32 v71, v107, v69
  v_or_b32 v70, v70, v71
  v_xor_b32 v71, v129, v69
  v_xor_b32 v72, v131, v69
  v_or3_b32 v70, v70, v71, v72
  v_xor_b32 v71, v109, v69
  v_or_b32 v70, v70, v71
  v_xor_b32 v71, v133, v69
  v_xor_b32 v72, v135, v69
  v_or3_b32 v70, v70, v71, v72
  v_xor_b32 v71, v111, v69
  v_or_b32 v70, v70, v71
  v_xor_b32 v71, v137, v69
  v_xor_b32 v72, v139, v69
  v_or3_b32 v70, v70, v71, v72
  v_xor_b32 v71, v113, v69
  v_or_b32 v70, v70, v71
  v_xor_b32 v71, v141, v69
  v_xor_b32 v72, v143, v69
  v_or3_b32 v70, v70, v71, v72
  v_xor_b32 v71, v115, v69
  v_or_b32 v70, v70, v71
  v_xor_b32 v71, v145, v69
  v_xor_b32 v72, v147, v69
  v_or3_b32 v70, v70, v71, v72
  v_cmp_ne_u32 vcc, 0, v70
  s_nop 4
  s_cbranch_vccz LA_cgo
  s_sub_u32 s62, s62, 1
  s_cmp_eq_u32 s62, 0
  s_cbranch_scc1 LA_fin
  s_sleep 1
  s_branch LA_cpoll
LA_cgo:
  v_max3_f32 v36, v116, v120, v124
  v_max3_f32 v37, v128, v132, v136
  v_max3_f32 v36, v36, v140, v144
  v_max_f32 v36, v36, v37
  v_mul_f32 v37, s86, v36
  v_fma_f32 v116, v116, s86, -v37
  v_fma_f32 v120, v120, s86, -v37
  v_fma_f32 v124, v124, s86, -v37
  v_fma_f32 v128, v128, s86, -v37
  v_fma_f32 v132, v132, s86, -v37
  v_fma_f32 v136, v136, s86, -v37
  v_fma_f32 v140, v140, s86, -v37
  v_fma_f32 v144, v144, s86, -v37
  v_exp_f32 v116, v116
  v_exp_f32 v120, v120
  v_exp_f32 v124, v124
  v_exp_f32 v128, v128
  v_exp_f32 v132, v132
  v_exp_f32 v136, v136
  v_exp_f32 v140, v140
  v_exp_f32 v144, v144
  v_mul_f32 v38, v100, v116
  v_mul_f32 v39, v118, v116
  v_fmac_f32 v38, v102, v120
  v_fmac_f32 v39, v122, v120
  v_fmac_f32 v38, v104, v124
  v_fmac_f32 v39, v126, v124
  v_fmac_f32 v38, v106, v128
  v_fmac_f32 v39, v130, v128
  v_fmac_f32 v38, v108, v132
  v_fmac_f32 v39, v134, v132
  v_fmac_f32 v38, v110, v136
  v_fmac_f32 v39, v138, v136
  v_fmac_f32 v38, v112, v140
  v_fmac_f32 v39, v142, v140
  v_fmac_f32 v38, v114, v144
  v_fmac_f32 v39, v146, v144
  v_rcp_f32 v39, v39
  s_nop 0
  v_mul_f32 v38, v38, v39
  v_cvt_pk_bf16_f32 v38, v38, v38
  v_lshlrev_b32 v40, 1, v0
  s_lshl_b32 s87, s73, 9
  s_mov_b64 s[64:65], s[34:35]
  s_mov_b32 s66, 16384
  s_mov_b32 s67, 0x20000
  buffer_store_short v38, v40, s[64:67], s87 offen
LA_fin:
LA_done:
  s_endpgm

.section .rodata,"a"
.p2align 6
.amdhsa_kernel standalone__kv_cache_quant_pre_rope_vs_post_rope__sampling_kernel
  .amdhsa_next_free_vgpr 196
  .amdhsa_next_free_sgpr 102
  .amdhsa_accum_offset 196
  .amdhsa_group_segment_fixed_size 0
  .amdhsa_kernarg_size 112
  .amdhsa_user_sgpr_count 2
  .amdhsa_user_sgpr_kernarg_segment_ptr 1
  .amdhsa_system_sgpr_workgroup_id_x 1
  .amdhsa_float_denorm_mode_32 3
.end_amdhsa_kernel
```
